```python
import torch

def _softmax(x, axis=-1):
    return torch.softmax(x, dim=axis)
def _gelu(x):
    return torch.nn.functional.gelu(x, approximate="tanh")
def _silu(x):
    return torch.nn.functional.silu(x)
def _sigmoid(x):
    return torch.sigmoid(x)
def _layernorm(x, axis=-1, eps=1e-5):
    m = x.mean(dim=axis, keepdim=True)
    v = x.var(dim=axis, keepdim=True, unbiased=False)
    return (x - m) / torch.sqrt(v + eps)
def _scatter_add(tgt, idx, src, axis=0):
    return tgt.clone().index_add_(axis, idx, src)
def _segment_sum(src, seg, n):
    out = torch.zeros((n,) + src.shape[1:], dtype=src.dtype)
    return out.index_add_(0, seg, src)
def _pad(x, pw):
    flat = tuple(v for pair in reversed(pw) for v in pair)
    return torch.nn.functional.pad(x, flat)

kernel_name = 'standalone__channel_attn_se__vision'

def setup_inputs():

    _w = (lambda a: (lambda t: t.to(torch.bfloat16) if t.is_floating_point() else t)(torch.as_tensor(a)))
    H = W = 384
    C = 192
    r = max(C // 16, 4)
    return {
        "x": _w((lambda *s: torch.randn(*s, dtype=torch.bfloat16) * 3.2)(1, H, W, C)),
        "w_down": _w((lambda *s: torch.randn(*s, dtype=torch.bfloat16) * 3.2)(C, r)),
        "w_up": _w((lambda *s: torch.randn(*s, dtype=torch.bfloat16) * 3.2)(r, C)),
    }

def reference(x, w_down, w_up):
    s = x.mean(axis=(1, 2))
    h = _silu(torch.einsum('bc,cr->br', s, w_down))
    g = _sigmoid(torch.einsum('br,rc->bc', h, w_up))
    return x * g[:, None, None, :]
```

```asm
; @launch grid=(256,1,1) block=(640,1,1) lds=6912
.amdgcn_target "amdgcn-amd-amdhsa--gfx950"
.text
.globl standalone__channel_attn_se__vision_kernel
.p2align 8
.type standalone__channel_attn_se__vision_kernel,@function
standalone__channel_attn_se__vision_kernel:
    s_load_dwordx2 s[16:17], s[0:1], 0
    v_readfirstlane_b32 s36, v0
    v_and_b32 v0, 63, v0
    s_mul_i32 s39, s2, 24576
    s_mov_b32 s18, 56623104
    s_mov_b32 s19, 0x20000
    v_mul_u32_u24 v1, 12, v0
    s_and_b32 s37, s2, 1
    s_mulk_i32 s37, -224
    s_add_u32 s37, s37, s36
    s_mulk_i32 s37, 96
    s_add_u32 s39, s39, s37
    s_cmpk_ge_u32 s2, 256
    s_cbranch_scc1 L_end
    s_cmpk_ge_u32 s36, 512
    s_cbranch_scc1 L_aux
    s_waitcnt lgkmcnt(0)
    buffer_load_dwordx3 v[16:18], v1, s[16:19], s39 offen offset:0 nt
    buffer_load_dwordx3 v[20:22], v1, s[16:19], s39 offen offset:768 nt
    buffer_load_dwordx3 v[24:26], v1, s[16:19], s39 offen offset:1536 nt
    buffer_load_dwordx3 v[28:30], v1, s[16:19], s39 offen offset:2304 nt
    s_load_dwordx2 s[20:21], s[0:1], 24
    s_load_dwordx2 s[72:73], s[0:1], 32
    s_mov_b32 s41, s39
    s_mov_b32 s22, 56623104
    s_mov_b32 s23, 0x20000
    s_movk_i32 s74, 0x100
    s_mov_b32 s75, 0x20000
    s_mov_b32 s42, 0xffff0000
    v_and_b32 v3, 31, v0
    v_mul_u32_u24 v3, 24, v3
    s_bfe_u32 s38, s36, 0x40004
    s_and_b32 s37, s36, 0x100
    s_lshl2_add_u32 s38, s37, s38
    v_lshl_add_u32 v2, v0, 4, s38
    s_getreg_b32 s40, hwreg(HW_REG_XCC_ID)
    s_lshr_b32 s43, s2, 3
    s_and_b32 s44, s2, 3
    s_lshl2_add_u32 s44, s43, s44
    s_mul_i32 s44, s44, 49152
    s_mul_i32 s38, s36, 48
    s_add_u32 s44, s44, s38
    s_and_b32 s45, s43, 1
    s_lshl_b32 s45, s45, 2
    s_lshr_b32 s45, 0x474, s45
    s_lshr_b32 s43, s43, 1
    s_waitcnt lgkmcnt(0)
    s_bfe_u32 s51, s45, 0x40000
    s_mul_i32 s60, s51, 6291456
    s_add_u32 s60, s60, s44
    s_add_u32 s58, s51, s43
    s_and_b32 s58, s58, 3
    s_cmp_ge_u32 s51, 6
    s_cselect_b32 s52, 23, 11
    s_cselect_b32 s55, 4, 0
    s_add_u32 s55, s55, s58
    s_add_u32 s58, s60, s20
    s_add_u32 s58, s58, 1536
    s_lshr_b32 s76, s58, 8
    s_xor_b32 s76, s76, s58
    s_lshr_b32 s76, s76, 13
    s_bfe_u32 s51, s45, 0x40004
    s_mul_i32 s61, s51, 6291456
    s_add_u32 s61, s61, s44
    s_add_u32 s58, s51, s43
    s_and_b32 s58, s58, 3
    s_cmp_ge_u32 s51, 6
    s_cselect_b32 s53, 23, 11
    s_cselect_b32 s56, 4, 0
    s_add_u32 s56, s56, s58
    s_add_u32 s58, s61, s20
    s_add_u32 s58, s58, 1536
    s_lshr_b32 s77, s58, 8
    s_xor_b32 s77, s77, s58
    s_lshr_b32 s77, s77, 13
    s_mov_b32 s49, 3000000
    s_add_u32 s45, s16, 0x100800
    s_add_u32 s46, s20, 0x100800
    s_xor_b32 s45, s45, s46
    s_lshr_b32 s46, s45, 8
    s_xor_b32 s45, s45, s46
    s_bitcmp1_b32 s45, 13
    s_cselect_b32 s45, -1, 0
    s_sub_u32 s46, s16, s20
    s_add_u32 s46, s46, 0x800
    s_bitcmp1_b32 s46, 12
    s_cselect_b32 s46, 0, -1
    s_cselect_b32 s59, 7, 19
    s_mul_i32 s59, s59, 0x41041
    s_add_u32 s39, s39, 6291456
    buffer_load_dwordx3 v[32:34], v1, s[16:19], s39 offen offset:0 nt
    s_waitcnt vmcnt(4)
    buffer_load_dwordx3 v[36:38], v1, s[16:19], s39 offen offset:768 nt
    v_lshlrev_b32 v4, 16, v16
    v_and_b32 v5, s42, v16
    v_lshlrev_b32 v6, 16, v17
    v_and_b32 v7, s42, v17
    v_lshlrev_b32 v8, 16, v18
    v_and_b32 v9, s42, v18
    s_waitcnt vmcnt(4)
    buffer_load_dwordx3 v[40:42], v1, s[16:19], s39 offen offset:1536 nt
    v_lshlrev_b32 v10, 16, v20
    v_and_b32 v11, s42, v20
    v_lshlrev_b32 v12, 16, v21
    v_and_b32 v13, s42, v21
    v_lshlrev_b32 v14, 16, v22
    v_and_b32 v15, s42, v22
    v_pk_add_f32 v[4:5], v[4:5], v[10:11]
    v_pk_add_f32 v[6:7], v[6:7], v[12:13]
    v_pk_add_f32 v[8:9], v[8:9], v[14:15]
    s_waitcnt vmcnt(4)
    buffer_load_dwordx3 v[44:46], v1, s[16:19], s39 offen offset:2304 nt
    v_lshlrev_b32 v10, 16, v24
    v_and_b32 v11, s42, v24
    v_lshlrev_b32 v12, 16, v25
    v_and_b32 v13, s42, v25
    v_lshlrev_b32 v14, 16, v26
    v_and_b32 v15, s42, v26
    v_pk_add_f32 v[4:5], v[4:5], v[10:11]
    v_pk_add_f32 v[6:7], v[6:7], v[12:13]
    v_pk_add_f32 v[8:9], v[8:9], v[14:15]
    s_waitcnt vmcnt(4)
    s_add_u32 s39, s39, 6291456
    buffer_load_dwordx3 v[48:50], v1, s[16:19], s39 offen offset:0 nt
    v_lshlrev_b32 v10, 16, v28
    v_and_b32 v11, s42, v28
    v_lshlrev_b32 v12, 16, v29
    v_and_b32 v13, s42, v29
    v_lshlrev_b32 v14, 16, v30
    v_and_b32 v15, s42, v30
    v_pk_add_f32 v[4:5], v[4:5], v[10:11]
    v_pk_add_f32 v[6:7], v[6:7], v[12:13]
    v_pk_add_f32 v[8:9], v[8:9], v[14:15]
    s_waitcnt vmcnt(4)
    buffer_load_dwordx3 v[52:54], v1, s[16:19], s39 offen offset:768 nt
    v_lshlrev_b32 v10, 16, v32
    v_and_b32 v11, s42, v32
    v_lshlrev_b32 v12, 16, v33
    v_and_b32 v13, s42, v33
    v_lshlrev_b32 v14, 16, v34
    v_and_b32 v15, s42, v34
    v_pk_add_f32 v[4:5], v[4:5], v[10:11]
    v_pk_add_f32 v[6:7], v[6:7], v[12:13]
    v_pk_add_f32 v[8:9], v[8:9], v[14:15]
    s_waitcnt vmcnt(4)
    buffer_load_dwordx3 v[56:58], v1, s[16:19], s39 offen offset:1536 nt
    v_lshlrev_b32 v10, 16, v36
    v_and_b32 v11, s42, v36
    v_lshlrev_b32 v12, 16, v37
    v_and_b32 v13, s42, v37
    v_lshlrev_b32 v14, 16, v38
    v_and_b32 v15, s42, v38
    v_pk_add_f32 v[4:5], v[4:5], v[10:11]
    v_pk_add_f32 v[6:7], v[6:7], v[12:13]
    v_pk_add_f32 v[8:9], v[8:9], v[14:15]
    s_waitcnt vmcnt(4)
    buffer_load_dwordx3 v[60:62], v1, s[16:19], s39 offen offset:2304 nt
    v_lshlrev_b32 v10, 16, v40
    v_and_b32 v11, s42, v40
    v_lshlrev_b32 v12, 16, v41
    v_and_b32 v13, s42, v41
    v_lshlrev_b32 v14, 16, v42
    v_and_b32 v15, s42, v42
    v_pk_add_f32 v[4:5], v[4:5], v[10:11]
    v_pk_add_f32 v[6:7], v[6:7], v[12:13]
    v_pk_add_f32 v[8:9], v[8:9], v[14:15]
    s_waitcnt vmcnt(4)
    s_add_u32 s39, s39, 6291456
    buffer_load_dwordx3 v[64:66], v1, s[16:19], s39 offen offset:0 nt
    v_lshlrev_b32 v10, 16, v44
    v_and_b32 v11, s42, v44
    v_lshlrev_b32 v12, 16, v45
    v_and_b32 v13, s42, v45
    v_lshlrev_b32 v14, 16, v46
    v_and_b32 v15, s42, v46
    v_pk_add_f32 v[4:5], v[4:5], v[10:11]
    v_pk_add_f32 v[6:7], v[6:7], v[12:13]
    v_pk_add_f32 v[8:9], v[8:9], v[14:15]
    s_waitcnt vmcnt(4)
    buffer_load_dwordx3 v[68:70], v1, s[16:19], s39 offen offset:768 nt
    v_lshlrev_b32 v10, 16, v48
    v_and_b32 v11, s42, v48
    v_lshlrev_b32 v12, 16, v49
    v_and_b32 v13, s42, v49
    v_lshlrev_b32 v14, 16, v50
    v_and_b32 v15, s42, v50
    v_pk_add_f32 v[4:5], v[4:5], v[10:11]
    v_pk_add_f32 v[6:7], v[6:7], v[12:13]
    v_pk_add_f32 v[8:9], v[8:9], v[14:15]
    s_waitcnt vmcnt(4)
    buffer_load_dwordx3 v[72:74], v1, s[16:19], s39 offen offset:1536 nt
    v_lshlrev_b32 v10, 16, v52
    v_and_b32 v11, s42, v52
    v_lshlrev_b32 v12, 16, v53
    v_and_b32 v13, s42, v53
    v_lshlrev_b32 v14, 16, v54
    v_and_b32 v15, s42, v54
    v_pk_add_f32 v[4:5], v[4:5], v[10:11]
    v_pk_add_f32 v[6:7], v[6:7], v[12:13]
    v_pk_add_f32 v[8:9], v[8:9], v[14:15]
    s_waitcnt vmcnt(4)
    buffer_load_dwordx3 v[76:78], v1, s[16:19], s39 offen offset:2304 nt
    v_lshlrev_b32 v10, 16, v56
    v_and_b32 v11, s42, v56
    v_lshlrev_b32 v12, 16, v57
    v_and_b32 v13, s42, v57
    v_lshlrev_b32 v14, 16, v58
    v_and_b32 v15, s42, v58
    v_pk_add_f32 v[4:5], v[4:5], v[10:11]
    v_pk_add_f32 v[6:7], v[6:7], v[12:13]
    v_pk_add_f32 v[8:9], v[8:9], v[14:15]
    s_waitcnt vmcnt(4)
    s_add_u32 s39, s39, 12582912
    buffer_load_dwordx3 v[80:82], v1, s[16:19], s39 offen offset:0 nt
    v_lshlrev_b32 v10, 16, v60
    v_and_b32 v11, s42, v60
    v_lshlrev_b32 v12, 16, v61
    v_and_b32 v13, s42, v61
    v_lshlrev_b32 v14, 16, v62
    v_and_b32 v15, s42, v62
    v_pk_add_f32 v[4:5], v[4:5], v[10:11]
    v_pk_add_f32 v[6:7], v[6:7], v[12:13]
    v_pk_add_f32 v[8:9], v[8:9], v[14:15]
    s_waitcnt vmcnt(4)
    buffer_load_dwordx3 v[84:86], v1, s[16:19], s39 offen offset:768 nt
    v_lshlrev_b32 v10, 16, v64
    v_and_b32 v11, s42, v64
    v_lshlrev_b32 v12, 16, v65
    v_and_b32 v13, s42, v65
    v_lshlrev_b32 v14, 16, v66
    v_and_b32 v15, s42, v66
    v_pk_add_f32 v[4:5], v[4:5], v[10:11]
    v_pk_add_f32 v[6:7], v[6:7], v[12:13]
    v_pk_add_f32 v[8:9], v[8:9], v[14:15]
    s_waitcnt vmcnt(4)
    buffer_load_dwordx3 v[88:90], v1, s[16:19], s39 offen offset:1536 nt
    v_lshlrev_b32 v10, 16, v68
    v_and_b32 v11, s42, v68
    v_lshlrev_b32 v12, 16, v69
    v_and_b32 v13, s42, v69
    v_lshlrev_b32 v14, 16, v70
    v_and_b32 v15, s42, v70
    v_pk_add_f32 v[4:5], v[4:5], v[10:11]
    v_pk_add_f32 v[6:7], v[6:7], v[12:13]
    v_pk_add_f32 v[8:9], v[8:9], v[14:15]
    s_waitcnt vmcnt(4)
    buffer_load_dwordx3 v[92:94], v1, s[16:19], s39 offen offset:2304 nt
    v_lshlrev_b32 v10, 16, v72
    v_and_b32 v11, s42, v72
    v_lshlrev_b32 v12, 16, v73
    v_and_b32 v13, s42, v73
    v_lshlrev_b32 v14, 16, v74
    v_and_b32 v15, s42, v74
    v_pk_add_f32 v[4:5], v[4:5], v[10:11]
    v_pk_add_f32 v[6:7], v[6:7], v[12:13]
    v_pk_add_f32 v[8:9], v[8:9], v[14:15]
    s_waitcnt vmcnt(4)
    s_add_u32 s39, s39, 6291456
    buffer_load_dwordx3 v[96:98], v1, s[16:19], s39 offen offset:0 nt
    v_lshlrev_b32 v10, 16, v76
    v_and_b32 v11, s42, v76
    v_lshlrev_b32 v12, 16, v77
    v_and_b32 v13, s42, v77
    v_lshlrev_b32 v14, 16, v78
    v_and_b32 v15, s42, v78
    v_pk_add_f32 v[4:5], v[4:5], v[10:11]
    v_pk_add_f32 v[6:7], v[6:7], v[12:13]
    v_pk_add_f32 v[8:9], v[8:9], v[14:15]
    s_waitcnt vmcnt(4)
    buffer_load_dwordx3 v[100:102], v1, s[16:19], s39 offen offset:768 nt
    v_lshlrev_b32 v10, 16, v80
    v_and_b32 v11, s42, v80
    v_lshlrev_b32 v12, 16, v81
    v_and_b32 v13, s42, v81
    v_lshlrev_b32 v14, 16, v82
    v_and_b32 v15, s42, v82
    v_pk_add_f32 v[4:5], v[4:5], v[10:11]
    v_pk_add_f32 v[6:7], v[6:7], v[12:13]
    v_pk_add_f32 v[8:9], v[8:9], v[14:15]
    s_waitcnt vmcnt(4)
    buffer_load_dwordx3 v[104:106], v1, s[16:19], s39 offen offset:1536 nt
    v_lshlrev_b32 v10, 16, v84
    v_and_b32 v11, s42, v84
    v_lshlrev_b32 v12, 16, v85
    v_and_b32 v13, s42, v85
    v_lshlrev_b32 v14, 16, v86
    v_and_b32 v15, s42, v86
    v_pk_add_f32 v[4:5], v[4:5], v[10:11]
    v_pk_add_f32 v[6:7], v[6:7], v[12:13]
    v_pk_add_f32 v[8:9], v[8:9], v[14:15]
    s_waitcnt vmcnt(4)
    buffer_load_dwordx3 v[108:110], v1, s[16:19], s39 offen offset:2304 nt
    buffer_load_dwordx2 v[160:161], off, s[72:75], 0 offset:128 sc1
    v_lshlrev_b32 v10, 16, v88
    v_and_b32 v11, s42, v88
    v_lshlrev_b32 v12, 16, v89
    v_and_b32 v13, s42, v89
    v_lshlrev_b32 v14, 16, v90
    v_and_b32 v15, s42, v90
    v_pk_add_f32 v[4:5], v[4:5], v[10:11]
    v_pk_add_f32 v[6:7], v[6:7], v[12:13]
    v_pk_add_f32 v[8:9], v[8:9], v[14:15]
    s_waitcnt vmcnt(5)
    s_add_u32 s39, s39, 12582912
    buffer_load_dwordx3 v[112:114], v1, s[16:19], s39 offen offset:0 nt
    v_lshlrev_b32 v10, 16, v92
    v_and_b32 v11, s42, v92
    v_lshlrev_b32 v12, 16, v93
    v_and_b32 v13, s42, v93
    v_lshlrev_b32 v14, 16, v94
    v_and_b32 v15, s42, v94
    v_pk_add_f32 v[4:5], v[4:5], v[10:11]
    v_pk_add_f32 v[6:7], v[6:7], v[12:13]
    v_pk_add_f32 v[8:9], v[8:9], v[14:15]
    s_waitcnt vmcnt(5)
    buffer_load_dwordx3 v[116:118], v1, s[16:19], s39 offen offset:768 nt
    v_lshlrev_b32 v10, 16, v96
    v_and_b32 v11, s42, v96
    v_lshlrev_b32 v12, 16, v97
    v_and_b32 v13, s42, v97
    v_lshlrev_b32 v14, 16, v98
    v_and_b32 v15, s42, v98
    v_pk_add_f32 v[4:5], v[4:5], v[10:11]
    v_pk_add_f32 v[6:7], v[6:7], v[12:13]
    v_pk_add_f32 v[8:9], v[8:9], v[14:15]
    s_waitcnt vmcnt(5)
    buffer_load_dwordx3 v[120:122], v1, s[16:19], s39 offen offset:1536 nt
    v_lshlrev_b32 v10, 16, v100
    v_and_b32 v11, s42, v100
    v_lshlrev_b32 v12, 16, v101
    v_and_b32 v13, s42, v101
    v_lshlrev_b32 v14, 16, v102
    v_and_b32 v15, s42, v102
    v_pk_add_f32 v[4:5], v[4:5], v[10:11]
    v_pk_add_f32 v[6:7], v[6:7], v[12:13]
    v_pk_add_f32 v[8:9], v[8:9], v[14:15]
    s_waitcnt vmcnt(5)
    buffer_load_dwordx3 v[124:126], v1, s[16:19], s39 offen offset:2304 nt
    v_lshlrev_b32 v10, 16, v104
    v_and_b32 v11, s42, v104
    v_lshlrev_b32 v12, 16, v105
    v_and_b32 v13, s42, v105
    v_lshlrev_b32 v14, 16, v106
    v_and_b32 v15, s42, v106
    v_pk_add_f32 v[4:5], v[4:5], v[10:11]
    v_pk_add_f32 v[6:7], v[6:7], v[12:13]
    v_pk_add_f32 v[8:9], v[8:9], v[14:15]
    s_waitcnt vmcnt(5)
    s_waitcnt vmcnt(4)
L_dchk:
    v_readfirstlane_b32 s47, v161
    v_readfirstlane_b32 s48, v160
    s_cmp_ge_u32 s47, 0x200000
    s_cbranch_scc0 L_dwait
L_dok:
    s_lshr_b32 s50, s47, 8
    s_add_u32 s50, s50, s2
    s_lshr_b32 s50, s50, 2
    s_add_u32 s48, s48, s59
    s_lshr_b32 s51, s48, 6
    s_xor_b32 s51, s51, s48
    s_xor_b32 s51, s51, s45
    s_and_b32 s51, s51, s46
    s_bitcmp1_b32 s51, 17
    s_cselect_b32 s47, 0x115, 0
    s_bitcmp1_b32 s51, 5
    s_cselect_b32 s47, s47, 0
    s_lshr_b32 s51, s48, s52
    s_xor_b32 s51, s51, s50
    s_lshr_b32 s58, s47, s55
    s_xor_b32 s51, s51, s58
    s_xor_b32 s51, s51, s76
    s_bitcmp1_b32 s51, 0
    s_cselect_b32 s58, 0x6000, 0
    s_add_u32 s60, s60, s58
    s_lshr_b32 s51, s48, s53
    s_xor_b32 s51, s51, s50
    s_lshr_b32 s58, s47, s56
    s_xor_b32 s51, s51, s58
    s_xor_b32 s51, s51, s77
    s_bitcmp1_b32 s51, 0
    s_cselect_b32 s58, 0x6000, 0
    s_add_u32 s61, s61, s58
    s_lshr_b32 s51, s47, 8
    s_andn2_b32 s51, s51, s40
    s_bitcmp1_b32 s51, 0
    s_cselect_b64 vcc, 0, -1
    buffer_load_dwordx3 v[128:130], v1, s[16:19], s60 offen offset:0 nt
    v_lshlrev_b32 v10, 16, v108
    v_and_b32 v11, s42, v108
    v_lshlrev_b32 v12, 16, v109
    v_and_b32 v13, s42, v109
    v_lshlrev_b32 v14, 16, v110
    v_and_b32 v15, s42, v110
    v_pk_add_f32 v[4:5], v[4:5], v[10:11]
    v_pk_add_f32 v[6:7], v[6:7], v[12:13]
    v_pk_add_f32 v[8:9], v[8:9], v[14:15]
    s_waitcnt vmcnt(4)
    buffer_load_dwordx3 v[132:134], v1, s[16:19], s60 offen offset:768 nt
    v_lshlrev_b32 v10, 16, v112
    v_and_b32 v11, s42, v112
    v_lshlrev_b32 v12, 16, v113
    v_and_b32 v13, s42, v113
    v_lshlrev_b32 v14, 16, v114
    v_and_b32 v15, s42, v114
    v_pk_add_f32 v[4:5], v[4:5], v[10:11]
    v_pk_add_f32 v[6:7], v[6:7], v[12:13]
    v_pk_add_f32 v[8:9], v[8:9], v[14:15]
    s_waitcnt vmcnt(4)
    buffer_load_dwordx3 v[136:138], v1, s[16:19], s60 offen offset:1536 nt
    v_lshlrev_b32 v10, 16, v116
    v_and_b32 v11, s42, v116
    v_lshlrev_b32 v12, 16, v117
    v_and_b32 v13, s42, v117
    v_lshlrev_b32 v14, 16, v118
    v_and_b32 v15, s42, v118
    v_pk_add_f32 v[4:5], v[4:5], v[10:11]
    v_pk_add_f32 v[6:7], v[6:7], v[12:13]
    v_pk_add_f32 v[8:9], v[8:9], v[14:15]
    s_waitcnt vmcnt(4)
    buffer_load_dwordx3 v[140:142], v1, s[16:19], s60 offen offset:2304 nt
    v_lshlrev_b32 v10, 16, v120
    v_and_b32 v11, s42, v120
    v_lshlrev_b32 v12, 16, v121
    v_and_b32 v13, s42, v121
    v_lshlrev_b32 v14, 16, v122
    v_and_b32 v15, s42, v122
    v_pk_add_f32 v[4:5], v[4:5], v[10:11]
    v_pk_add_f32 v[6:7], v[6:7], v[12:13]
    v_pk_add_f32 v[8:9], v[8:9], v[14:15]
    s_waitcnt vmcnt(4)
    buffer_load_dwordx3 v[144:146], v1, s[16:19], s61 offen offset:0 nt
    v_lshlrev_b32 v10, 16, v124
    v_and_b32 v11, s42, v124
    v_lshlrev_b32 v12, 16, v125
    v_and_b32 v13, s42, v125
    v_lshlrev_b32 v14, 16, v126
    v_and_b32 v15, s42, v126
    v_pk_add_f32 v[4:5], v[4:5], v[10:11]
    v_pk_add_f32 v[6:7], v[6:7], v[12:13]
    v_pk_add_f32 v[8:9], v[8:9], v[14:15]
    s_waitcnt vmcnt(4)
    buffer_load_dwordx3 v[148:150], v1, s[16:19], s61 offen offset:768 nt
    v_lshlrev_b32 v10, 16, v128
    v_and_b32 v11, s42, v128
    v_lshlrev_b32 v12, 16, v129
    v_and_b32 v13, s42, v129
    v_lshlrev_b32 v14, 16, v130
    v_and_b32 v15, s42, v130
    v_pk_add_f32 v[4:5], v[4:5], v[10:11]
    v_pk_add_f32 v[6:7], v[6:7], v[12:13]
    v_pk_add_f32 v[8:9], v[8:9], v[14:15]
    s_waitcnt vmcnt(4)
    buffer_load_dwordx3 v[152:154], v1, s[16:19], s61 offen offset:1536 nt
    v_lshlrev_b32 v10, 16, v132
    v_and_b32 v11, s42, v132
    v_lshlrev_b32 v12, 16, v133
    v_and_b32 v13, s42, v133
    v_lshlrev_b32 v14, 16, v134
    v_and_b32 v15, s42, v134
    v_pk_add_f32 v[4:5], v[4:5], v[10:11]
    v_pk_add_f32 v[6:7], v[6:7], v[12:13]
    v_pk_add_f32 v[8:9], v[8:9], v[14:15]
    s_waitcnt vmcnt(4)
    buffer_load_dwordx3 v[156:158], v1, s[16:19], s61 offen offset:2304 nt
    v_lshlrev_b32 v10, 16, v136
    v_and_b32 v11, s42, v136
    v_lshlrev_b32 v12, 16, v137
    v_and_b32 v13, s42, v137
    v_lshlrev_b32 v14, 16, v138
    v_and_b32 v15, s42, v138
    v_pk_add_f32 v[4:5], v[4:5], v[10:11]
    v_pk_add_f32 v[6:7], v[6:7], v[12:13]
    v_pk_add_f32 v[8:9], v[8:9], v[14:15]
    s_waitcnt vmcnt(4)
    v_lshlrev_b32 v10, 16, v140
    v_and_b32 v11, s42, v140
    v_lshlrev_b32 v12, 16, v141
    v_and_b32 v13, s42, v141
    v_lshlrev_b32 v14, 16, v142
    v_and_b32 v15, s42, v142
    v_pk_add_f32 v[4:5], v[4:5], v[10:11]
    v_pk_add_f32 v[6:7], v[6:7], v[12:13]
    v_pk_add_f32 v[8:9], v[8:9], v[14:15]
    s_waitcnt vmcnt(3)
    v_lshlrev_b32 v10, 16, v144
    v_and_b32 v11, s42, v144
    v_lshlrev_b32 v12, 16, v145
    v_and_b32 v13, s42, v145
    v_lshlrev_b32 v14, 16, v146
    v_and_b32 v15, s42, v146
    v_pk_add_f32 v[4:5], v[4:5], v[10:11]
    v_pk_add_f32 v[6:7], v[6:7], v[12:13]
    v_pk_add_f32 v[8:9], v[8:9], v[14:15]
    s_waitcnt vmcnt(2)
    v_lshlrev_b32 v10, 16, v148
    v_and_b32 v11, s42, v148
    v_lshlrev_b32 v12, 16, v149
    v_and_b32 v13, s42, v149
    v_lshlrev_b32 v14, 16, v150
    v_and_b32 v15, s42, v150
    v_pk_add_f32 v[4:5], v[4:5], v[10:11]
    v_pk_add_f32 v[6:7], v[6:7], v[12:13]
    v_pk_add_f32 v[8:9], v[8:9], v[14:15]
    s_waitcnt vmcnt(1)
    v_lshlrev_b32 v10, 16, v152
    v_and_b32 v11, s42, v152
    v_lshlrev_b32 v12, 16, v153
    v_and_b32 v13, s42, v153
    v_lshlrev_b32 v14, 16, v154
    v_and_b32 v15, s42, v154
    v_pk_add_f32 v[4:5], v[4:5], v[10:11]
    v_pk_add_f32 v[6:7], v[6:7], v[12:13]
    v_pk_add_f32 v[8:9], v[8:9], v[14:15]
    s_waitcnt vmcnt(0)
    v_lshlrev_b32 v10, 16, v156
    v_and_b32 v11, s42, v156
    v_lshlrev_b32 v12, 16, v157
    v_and_b32 v13, s42, v157
    v_lshlrev_b32 v14, 16, v158
    v_and_b32 v15, s42, v158
    v_pk_add_f32 v[4:5], v[4:5], v[10:11]
    v_pk_add_f32 v[6:7], v[6:7], v[12:13]
    v_pk_add_f32 v[8:9], v[8:9], v[14:15]
    s_nop 0
    v_permlane32_swap_b32 v4, v7
    v_permlane32_swap_b32 v5, v8
    v_permlane32_swap_b32 v6, v9
    v_add_f32 v4, v4, v7
    ds_write_b32 v2, v4 offset:0
    v_add_f32 v5, v5, v8
    ds_write_b32 v2, v5 offset:2048
    v_add_f32 v6, v6, v9
    ds_write_b32 v2, v6 offset:4096
    s_waitcnt lgkmcnt(0)
    s_barrier
    s_barrier
L_store:
    ds_read_b64 v[4:5], v3 offset:6144
    ds_read_b64 v[6:7], v3 offset:6152
    ds_read_b64 v[8:9], v3 offset:6160
    v_lshlrev_b32 v10, 16, v16
    v_and_b32 v11, s42, v16
    v_lshlrev_b32 v12, 16, v17
    v_and_b32 v13, s42, v17
    v_lshlrev_b32 v14, 16, v18
    v_and_b32 v15, s42, v18
    s_waitcnt lgkmcnt(0)
    v_pk_mul_f32 v[10:11], v[10:11], v[4:5]
    v_pk_mul_f32 v[12:13], v[12:13], v[6:7]
    v_pk_mul_f32 v[14:15], v[14:15], v[8:9]
    v_cvt_pk_bf16_f32 v16, v10, v11
    v_cvt_pk_bf16_f32 v17, v12, v13
    v_cvt_pk_bf16_f32 v18, v14, v15
    s_cbranch_execz L_sk0
    buffer_store_dwordx3 v[16:18], v1, s[20:23], s41 offen offset:0 sc1
L_sk0:
    v_lshlrev_b32 v10, 16, v20
    v_and_b32 v11, s42, v20
    v_lshlrev_b32 v12, 16, v21
    v_and_b32 v13, s42, v21
    v_lshlrev_b32 v14, 16, v22
    v_and_b32 v15, s42, v22
    v_pk_mul_f32 v[10:11], v[10:11], v[4:5]
    v_pk_mul_f32 v[12:13], v[12:13], v[6:7]
    v_pk_mul_f32 v[14:15], v[14:15], v[8:9]
    v_cvt_pk_bf16_f32 v20, v10, v11
    v_cvt_pk_bf16_f32 v21, v12, v13
    v_cvt_pk_bf16_f32 v22, v14, v15
    s_cbranch_execz L_sk1
    buffer_store_dwordx3 v[20:22], v1, s[20:23], s41 offen offset:768 sc1
L_sk1:
    v_lshlrev_b32 v10, 16, v24
    v_and_b32 v11, s42, v24
    v_lshlrev_b32 v12, 16, v25
    v_and_b32 v13, s42, v25
    v_lshlrev_b32 v14, 16, v26
    v_and_b32 v15, s42, v26
    v_pk_mul_f32 v[10:11], v[10:11], v[4:5]
    v_pk_mul_f32 v[12:13], v[12:13], v[6:7]
    v_pk_mul_f32 v[14:15], v[14:15], v[8:9]
    v_cvt_pk_bf16_f32 v24, v10, v11
    v_cvt_pk_bf16_f32 v25, v12, v13
    v_cvt_pk_bf16_f32 v26, v14, v15
    s_cbranch_execz L_sk2
    buffer_store_dwordx3 v[24:26], v1, s[20:23], s41 offen offset:1536 sc1
L_sk2:
    v_lshlrev_b32 v10, 16, v28
    v_and_b32 v11, s42, v28
    v_lshlrev_b32 v12, 16, v29
    v_and_b32 v13, s42, v29
    v_lshlrev_b32 v14, 16, v30
    v_and_b32 v15, s42, v30
    v_pk_mul_f32 v[10:11], v[10:11], v[4:5]
    v_pk_mul_f32 v[12:13], v[12:13], v[6:7]
    v_pk_mul_f32 v[14:15], v[14:15], v[8:9]
    v_cvt_pk_bf16_f32 v28, v10, v11
    v_cvt_pk_bf16_f32 v29, v12, v13
    v_cvt_pk_bf16_f32 v30, v14, v15
    s_cbranch_vccnz L_th3
    s_waitcnt vmcnt(0)
L_th3:
    s_cbranch_execz L_sk3
    buffer_store_dwordx3 v[28:30], v1, s[20:23], s41 offen offset:2304 sc1
L_sk3:
    v_lshlrev_b32 v10, 16, v128
    v_and_b32 v11, s42, v128
    v_lshlrev_b32 v12, 16, v129
    v_and_b32 v13, s42, v129
    v_lshlrev_b32 v14, 16, v130
    v_and_b32 v15, s42, v130
    v_pk_mul_f32 v[10:11], v[10:11], v[4:5]
    v_pk_mul_f32 v[12:13], v[12:13], v[6:7]
    v_pk_mul_f32 v[14:15], v[14:15], v[8:9]
    v_cvt_pk_bf16_f32 v128, v10, v11
    v_cvt_pk_bf16_f32 v129, v12, v13
    v_cvt_pk_bf16_f32 v130, v14, v15
    s_cbranch_execz L_sk4
    buffer_store_dwordx3 v[128:130], v1, s[20:23], s60 offen offset:0 sc1
L_sk4:
    v_lshlrev_b32 v10, 16, v32
    v_and_b32 v11, s42, v32
    v_lshlrev_b32 v12, 16, v33
    v_and_b32 v13, s42, v33
    v_lshlrev_b32 v14, 16, v34
    v_and_b32 v15, s42, v34
    v_pk_mul_f32 v[10:11], v[10:11], v[4:5]
    v_pk_mul_f32 v[12:13], v[12:13], v[6:7]
    v_pk_mul_f32 v[14:15], v[14:15], v[8:9]
    v_cvt_pk_bf16_f32 v32, v10, v11
    v_cvt_pk_bf16_f32 v33, v12, v13
    v_cvt_pk_bf16_f32 v34, v14, v15
    s_add_u32 s41, s41, 6291456
    s_cbranch_execz L_sk5
    buffer_store_dwordx3 v[32:34], v1, s[20:23], s41 offen offset:0 sc1
L_sk5:
    v_lshlrev_b32 v10, 16, v36
    v_and_b32 v11, s42, v36
    v_lshlrev_b32 v12, 16, v37
    v_and_b32 v13, s42, v37
    v_lshlrev_b32 v14, 16, v38
    v_and_b32 v15, s42, v38
    v_pk_mul_f32 v[10:11], v[10:11], v[4:5]
    v_pk_mul_f32 v[12:13], v[12:13], v[6:7]
    v_pk_mul_f32 v[14:15], v[14:15], v[8:9]
    v_cvt_pk_bf16_f32 v36, v10, v11
    v_cvt_pk_bf16_f32 v37, v12, v13
    v_cvt_pk_bf16_f32 v38, v14, v15
    s_cbranch_vccnz L_th6
    s_waitcnt vmcnt(0)
L_th6:
    s_cbranch_execz L_sk6
    buffer_store_dwordx3 v[36:38], v1, s[20:23], s41 offen offset:768 sc1
L_sk6:
    v_lshlrev_b32 v10, 16, v40
    v_and_b32 v11, s42, v40
    v_lshlrev_b32 v12, 16, v41
    v_and_b32 v13, s42, v41
    v_lshlrev_b32 v14, 16, v42
    v_and_b32 v15, s42, v42
    v_pk_mul_f32 v[10:11], v[10:11], v[4:5]
    v_pk_mul_f32 v[12:13], v[12:13], v[6:7]
    v_pk_mul_f32 v[14:15], v[14:15], v[8:9]
    v_cvt_pk_bf16_f32 v40, v10, v11
    v_cvt_pk_bf16_f32 v41, v12, v13
    v_cvt_pk_bf16_f32 v42, v14, v15
    s_cbranch_execz L_sk7
    buffer_store_dwordx3 v[40:42], v1, s[20:23], s41 offen offset:1536 sc1
L_sk7:
    v_lshlrev_b32 v10, 16, v132
    v_and_b32 v11, s42, v132
    v_lshlrev_b32 v12, 16, v133
    v_and_b32 v13, s42, v133
    v_lshlrev_b32 v14, 16, v134
    v_and_b32 v15, s42, v134
    v_pk_mul_f32 v[10:11], v[10:11], v[4:5]
    v_pk_mul_f32 v[12:13], v[12:13], v[6:7]
    v_pk_mul_f32 v[14:15], v[14:15], v[8:9]
    v_cvt_pk_bf16_f32 v132, v10, v11
    v_cvt_pk_bf16_f32 v133, v12, v13
    v_cvt_pk_bf16_f32 v134, v14, v15
    s_cbranch_execz L_sk8
    buffer_store_dwordx3 v[132:134], v1, s[20:23], s60 offen offset:768 sc1
L_sk8:
    v_lshlrev_b32 v10, 16, v44
    v_and_b32 v11, s42, v44
    v_lshlrev_b32 v12, 16, v45
    v_and_b32 v13, s42, v45
    v_lshlrev_b32 v14, 16, v46
    v_and_b32 v15, s42, v46
    v_pk_mul_f32 v[10:11], v[10:11], v[4:5]
    v_pk_mul_f32 v[12:13], v[12:13], v[6:7]
    v_pk_mul_f32 v[14:15], v[14:15], v[8:9]
    v_cvt_pk_bf16_f32 v44, v10, v11
    v_cvt_pk_bf16_f32 v45, v12, v13
    v_cvt_pk_bf16_f32 v46, v14, v15
    s_cbranch_vccnz L_th9
    s_waitcnt vmcnt(0)
L_th9:
    s_cbranch_execz L_sk9
    buffer_store_dwordx3 v[44:46], v1, s[20:23], s41 offen offset:2304 sc1
L_sk9:
    v_lshlrev_b32 v10, 16, v48
    v_and_b32 v11, s42, v48
    v_lshlrev_b32 v12, 16, v49
    v_and_b32 v13, s42, v49
    v_lshlrev_b32 v14, 16, v50
    v_and_b32 v15, s42, v50
    v_pk_mul_f32 v[10:11], v[10:11], v[4:5]
    v_pk_mul_f32 v[12:13], v[12:13], v[6:7]
    v_pk_mul_f32 v[14:15], v[14:15], v[8:9]
    v_cvt_pk_bf16_f32 v48, v10, v11
    v_cvt_pk_bf16_f32 v49, v12, v13
    v_cvt_pk_bf16_f32 v50, v14, v15
    s_add_u32 s41, s41, 6291456
    s_cbranch_execz L_sk10
    buffer_store_dwordx3 v[48:50], v1, s[20:23], s41 offen offset:0 sc1
L_sk10:
    v_lshlrev_b32 v10, 16, v52
    v_and_b32 v11, s42, v52
    v_lshlrev_b32 v12, 16, v53
    v_and_b32 v13, s42, v53
    v_lshlrev_b32 v14, 16, v54
    v_and_b32 v15, s42, v54
    v_pk_mul_f32 v[10:11], v[10:11], v[4:5]
    v_pk_mul_f32 v[12:13], v[12:13], v[6:7]
    v_pk_mul_f32 v[14:15], v[14:15], v[8:9]
    v_cvt_pk_bf16_f32 v52, v10, v11
    v_cvt_pk_bf16_f32 v53, v12, v13
    v_cvt_pk_bf16_f32 v54, v14, v15
    s_cbranch_execz L_sk11
    buffer_store_dwordx3 v[52:54], v1, s[20:23], s41 offen offset:768 sc1
L_sk11:
    v_lshlrev_b32 v10, 16, v56
    v_and_b32 v11, s42, v56
    v_lshlrev_b32 v12, 16, v57
    v_and_b32 v13, s42, v57
    v_lshlrev_b32 v14, 16, v58
    v_and_b32 v15, s42, v58
    v_pk_mul_f32 v[10:11], v[10:11], v[4:5]
    v_pk_mul_f32 v[12:13], v[12:13], v[6:7]
    v_pk_mul_f32 v[14:15], v[14:15], v[8:9]
    v_cvt_pk_bf16_f32 v56, v10, v11
    v_cvt_pk_bf16_f32 v57, v12, v13
    v_cvt_pk_bf16_f32 v58, v14, v15
    s_cbranch_vccnz L_th12
    s_waitcnt vmcnt(0)
L_th12:
    s_cbranch_execz L_sk12
    buffer_store_dwordx3 v[56:58], v1, s[20:23], s41 offen offset:1536 sc1
L_sk12:
    v_lshlrev_b32 v10, 16, v136
    v_and_b32 v11, s42, v136
    v_lshlrev_b32 v12, 16, v137
    v_and_b32 v13, s42, v137
    v_lshlrev_b32 v14, 16, v138
    v_and_b32 v15, s42, v138
    v_pk_mul_f32 v[10:11], v[10:11], v[4:5]
    v_pk_mul_f32 v[12:13], v[12:13], v[6:7]
    v_pk_mul_f32 v[14:15], v[14:15], v[8:9]
    v_cvt_pk_bf16_f32 v136, v10, v11
    v_cvt_pk_bf16_f32 v137, v12, v13
    v_cvt_pk_bf16_f32 v138, v14, v15
    s_cbranch_execz L_sk13
    buffer_store_dwordx3 v[136:138], v1, s[20:23], s60 offen offset:1536 sc1
L_sk13:
    v_lshlrev_b32 v10, 16, v60
    v_and_b32 v11, s42, v60
    v_lshlrev_b32 v12, 16, v61
    v_and_b32 v13, s42, v61
    v_lshlrev_b32 v14, 16, v62
    v_and_b32 v15, s42, v62
    v_pk_mul_f32 v[10:11], v[10:11], v[4:5]
    v_pk_mul_f32 v[12:13], v[12:13], v[6:7]
    v_pk_mul_f32 v[14:15], v[14:15], v[8:9]
    v_cvt_pk_bf16_f32 v60, v10, v11
    v_cvt_pk_bf16_f32 v61, v12, v13
    v_cvt_pk_bf16_f32 v62, v14, v15
    s_cbranch_vccnz L_th14
    s_waitcnt vmcnt(0)
L_th14:
    s_cbranch_execz L_sk14
    buffer_store_dwordx3 v[60:62], v1, s[20:23], s41 offen offset:2304 sc1
L_sk14:
    v_lshlrev_b32 v10, 16, v64
    v_and_b32 v11, s42, v64
    v_lshlrev_b32 v12, 16, v65
    v_and_b32 v13, s42, v65
    v_lshlrev_b32 v14, 16, v66
    v_and_b32 v15, s42, v66
    v_pk_mul_f32 v[10:11], v[10:11], v[4:5]
    v_pk_mul_f32 v[12:13], v[12:13], v[6:7]
    v_pk_mul_f32 v[14:15], v[14:15], v[8:9]
    v_cvt_pk_bf16_f32 v64, v10, v11
    v_cvt_pk_bf16_f32 v65, v12, v13
    v_cvt_pk_bf16_f32 v66, v14, v15
    s_add_u32 s41, s41, 6291456
    s_cbranch_execz L_sk15
    buffer_store_dwordx3 v[64:66], v1, s[20:23], s41 offen offset:0 sc1
L_sk15:
    v_lshlrev_b32 v10, 16, v68
    v_and_b32 v11, s42, v68
    v_lshlrev_b32 v12, 16, v69
    v_and_b32 v13, s42, v69
    v_lshlrev_b32 v14, 16, v70
    v_and_b32 v15, s42, v70
    v_pk_mul_f32 v[10:11], v[10:11], v[4:5]
    v_pk_mul_f32 v[12:13], v[12:13], v[6:7]
    v_pk_mul_f32 v[14:15], v[14:15], v[8:9]
    v_cvt_pk_bf16_f32 v68, v10, v11
    v_cvt_pk_bf16_f32 v69, v12, v13
    v_cvt_pk_bf16_f32 v70, v14, v15
    s_cbranch_execz L_sk16
    buffer_store_dwordx3 v[68:70], v1, s[20:23], s41 offen offset:768 sc1
L_sk16:
    v_lshlrev_b32 v10, 16, v140
    v_and_b32 v11, s42, v140
    v_lshlrev_b32 v12, 16, v141
    v_and_b32 v13, s42, v141
    v_lshlrev_b32 v14, 16, v142
    v_and_b32 v15, s42, v142
    v_pk_mul_f32 v[10:11], v[10:11], v[4:5]
    v_pk_mul_f32 v[12:13], v[12:13], v[6:7]
    v_pk_mul_f32 v[14:15], v[14:15], v[8:9]
    v_cvt_pk_bf16_f32 v140, v10, v11
    v_cvt_pk_bf16_f32 v141, v12, v13
    v_cvt_pk_bf16_f32 v142, v14, v15
    s_cbranch_vccnz L_th17
    s_waitcnt vmcnt(0)
L_th17:
    s_cbranch_execz L_sk17
    buffer_store_dwordx3 v[140:142], v1, s[20:23], s60 offen offset:2304 sc1
L_sk17:
    v_lshlrev_b32 v10, 16, v72
    v_and_b32 v11, s42, v72
    v_lshlrev_b32 v12, 16, v73
    v_and_b32 v13, s42, v73
    v_lshlrev_b32 v14, 16, v74
    v_and_b32 v15, s42, v74
    v_pk_mul_f32 v[10:11], v[10:11], v[4:5]
    v_pk_mul_f32 v[12:13], v[12:13], v[6:7]
    v_pk_mul_f32 v[14:15], v[14:15], v[8:9]
    v_cvt_pk_bf16_f32 v72, v10, v11
    v_cvt_pk_bf16_f32 v73, v12, v13
    v_cvt_pk_bf16_f32 v74, v14, v15
    s_cbranch_execz L_sk18
    buffer_store_dwordx3 v[72:74], v1, s[20:23], s41 offen offset:1536 sc1
L_sk18:
    v_lshlrev_b32 v10, 16, v76
    v_and_b32 v11, s42, v76
    v_lshlrev_b32 v12, 16, v77
    v_and_b32 v13, s42, v77
    v_lshlrev_b32 v14, 16, v78
    v_and_b32 v15, s42, v78
    v_pk_mul_f32 v[10:11], v[10:11], v[4:5]
    v_pk_mul_f32 v[12:13], v[12:13], v[6:7]
    v_pk_mul_f32 v[14:15], v[14:15], v[8:9]
    v_cvt_pk_bf16_f32 v76, v10, v11
    v_cvt_pk_bf16_f32 v77, v12, v13
    v_cvt_pk_bf16_f32 v78, v14, v15
    s_cbranch_execz L_sk19
    buffer_store_dwordx3 v[76:78], v1, s[20:23], s41 offen offset:2304 sc1
L_sk19:
    v_lshlrev_b32 v10, 16, v80
    v_and_b32 v11, s42, v80
    v_lshlrev_b32 v12, 16, v81
    v_and_b32 v13, s42, v81
    v_lshlrev_b32 v14, 16, v82
    v_and_b32 v15, s42, v82
    v_pk_mul_f32 v[10:11], v[10:11], v[4:5]
    v_pk_mul_f32 v[12:13], v[12:13], v[6:7]
    v_pk_mul_f32 v[14:15], v[14:15], v[8:9]
    v_cvt_pk_bf16_f32 v80, v10, v11
    v_cvt_pk_bf16_f32 v81, v12, v13
    v_cvt_pk_bf16_f32 v82, v14, v15
    s_add_u32 s41, s41, 12582912
    s_cbranch_vccnz L_th20
    s_waitcnt vmcnt(0)
L_th20:
    s_cbranch_execz L_sk20
    buffer_store_dwordx3 v[80:82], v1, s[20:23], s41 offen offset:0 sc1
L_sk20:
    v_lshlrev_b32 v10, 16, v84
    v_and_b32 v11, s42, v84
    v_lshlrev_b32 v12, 16, v85
    v_and_b32 v13, s42, v85
    v_lshlrev_b32 v14, 16, v86
    v_and_b32 v15, s42, v86
    v_pk_mul_f32 v[10:11], v[10:11], v[4:5]
    v_pk_mul_f32 v[12:13], v[12:13], v[6:7]
    v_pk_mul_f32 v[14:15], v[14:15], v[8:9]
    v_cvt_pk_bf16_f32 v84, v10, v11
    v_cvt_pk_bf16_f32 v85, v12, v13
    v_cvt_pk_bf16_f32 v86, v14, v15
    s_cbranch_execz L_sk21
    buffer_store_dwordx3 v[84:86], v1, s[20:23], s41 offen offset:768 sc1
L_sk21:
    v_lshlrev_b32 v10, 16, v144
    v_and_b32 v11, s42, v144
    v_lshlrev_b32 v12, 16, v145
    v_and_b32 v13, s42, v145
    v_lshlrev_b32 v14, 16, v146
    v_and_b32 v15, s42, v146
    v_pk_mul_f32 v[10:11], v[10:11], v[4:5]
    v_pk_mul_f32 v[12:13], v[12:13], v[6:7]
    v_pk_mul_f32 v[14:15], v[14:15], v[8:9]
    v_cvt_pk_bf16_f32 v144, v10, v11
    v_cvt_pk_bf16_f32 v145, v12, v13
    v_cvt_pk_bf16_f32 v146, v14, v15
    s_cbranch_execz L_sk22
    buffer_store_dwordx3 v[144:146], v1, s[20:23], s61 offen offset:0 sc1
L_sk22:
    v_lshlrev_b32 v10, 16, v88
    v_and_b32 v11, s42, v88
    v_lshlrev_b32 v12, 16, v89
    v_and_b32 v13, s42, v89
    v_lshlrev_b32 v14, 16, v90
    v_and_b32 v15, s42, v90
    v_pk_mul_f32 v[10:11], v[10:11], v[4:5]
    v_pk_mul_f32 v[12:13], v[12:13], v[6:7]
    v_pk_mul_f32 v[14:15], v[14:15], v[8:9]
    v_cvt_pk_bf16_f32 v88, v10, v11
    v_cvt_pk_bf16_f32 v89, v12, v13
    v_cvt_pk_bf16_f32 v90, v14, v15
    s_cbranch_vccnz L_th23
    s_waitcnt vmcnt(0)
L_th23:
    s_cbranch_execz L_sk23
    buffer_store_dwordx3 v[88:90], v1, s[20:23], s41 offen offset:1536 sc1
L_sk23:
    v_lshlrev_b32 v10, 16, v92
    v_and_b32 v11, s42, v92
    v_lshlrev_b32 v12, 16, v93
    v_and_b32 v13, s42, v93
    v_lshlrev_b32 v14, 16, v94
    v_and_b32 v15, s42, v94
    v_pk_mul_f32 v[10:11], v[10:11], v[4:5]
    v_pk_mul_f32 v[12:13], v[12:13], v[6:7]
    v_pk_mul_f32 v[14:15], v[14:15], v[8:9]
    v_cvt_pk_bf16_f32 v92, v10, v11
    v_cvt_pk_bf16_f32 v93, v12, v13
    v_cvt_pk_bf16_f32 v94, v14, v15
    s_cbranch_execz L_sk24
    buffer_store_dwordx3 v[92:94], v1, s[20:23], s41 offen offset:2304 sc1
L_sk24:
    v_lshlrev_b32 v10, 16, v96
    v_and_b32 v11, s42, v96
    v_lshlrev_b32 v12, 16, v97
    v_and_b32 v13, s42, v97
    v_lshlrev_b32 v14, 16, v98
    v_and_b32 v15, s42, v98
    v_pk_mul_f32 v[10:11], v[10:11], v[4:5]
    v_pk_mul_f32 v[12:13], v[12:13], v[6:7]
    v_pk_mul_f32 v[14:15], v[14:15], v[8:9]
    v_cvt_pk_bf16_f32 v96, v10, v11
    v_cvt_pk_bf16_f32 v97, v12, v13
    v_cvt_pk_bf16_f32 v98, v14, v15
    s_add_u32 s41, s41, 6291456
    s_cbranch_vccnz L_th25
    s_waitcnt vmcnt(0)
L_th25:
    s_cbranch_execz L_sk25
    buffer_store_dwordx3 v[96:98], v1, s[20:23], s41 offen offset:0 sc1
L_sk25:
    v_lshlrev_b32 v10, 16, v148
    v_and_b32 v11, s42, v148
    v_lshlrev_b32 v12, 16, v149
    v_and_b32 v13, s42, v149
    v_lshlrev_b32 v14, 16, v150
    v_and_b32 v15, s42, v150
    v_pk_mul_f32 v[10:11], v[10:11], v[4:5]
    v_pk_mul_f32 v[12:13], v[12:13], v[6:7]
    v_pk_mul_f32 v[14:15], v[14:15], v[8:9]
    v_cvt_pk_bf16_f32 v148, v10, v11
    v_cvt_pk_bf16_f32 v149, v12, v13
    v_cvt_pk_bf16_f32 v150, v14, v15
    s_cbranch_execz L_sk26
    buffer_store_dwordx3 v[148:150], v1, s[20:23], s61 offen offset:768 sc1
L_sk26:
    v_lshlrev_b32 v10, 16, v100
    v_and_b32 v11, s42, v100
    v_lshlrev_b32 v12, 16, v101
    v_and_b32 v13, s42, v101
    v_lshlrev_b32 v14, 16, v102
    v_and_b32 v15, s42, v102
    v_pk_mul_f32 v[10:11], v[10:11], v[4:5]
    v_pk_mul_f32 v[12:13], v[12:13], v[6:7]
    v_pk_mul_f32 v[14:15], v[14:15], v[8:9]
    v_cvt_pk_bf16_f32 v100, v10, v11
    v_cvt_pk_bf16_f32 v101, v12, v13
    v_cvt_pk_bf16_f32 v102, v14, v15
    s_cbranch_execz L_sk27
    buffer_store_dwordx3 v[100:102], v1, s[20:23], s41 offen offset:768 sc1
L_sk27:
    v_lshlrev_b32 v10, 16, v104
    v_and_b32 v11, s42, v104
    v_lshlrev_b32 v12, 16, v105
    v_and_b32 v13, s42, v105
    v_lshlrev_b32 v14, 16, v106
    v_and_b32 v15, s42, v106
    v_pk_mul_f32 v[10:11], v[10:11], v[4:5]
    v_pk_mul_f32 v[12:13], v[12:13], v[6:7]
    v_pk_mul_f32 v[14:15], v[14:15], v[8:9]
    v_cvt_pk_bf16_f32 v104, v10, v11
    v_cvt_pk_bf16_f32 v105, v12, v13
    v_cvt_pk_bf16_f32 v106, v14, v15
    s_cbranch_vccnz L_th28
    s_waitcnt vmcnt(0)
L_th28:
    s_cbranch_execz L_sk28
    buffer_store_dwordx3 v[104:106], v1, s[20:23], s41 offen offset:1536 sc1
L_sk28:
    v_lshlrev_b32 v10, 16, v108
    v_and_b32 v11, s42, v108
    v_lshlrev_b32 v12, 16, v109
    v_and_b32 v13, s42, v109
    v_lshlrev_b32 v14, 16, v110
    v_and_b32 v15, s42, v110
    v_pk_mul_f32 v[10:11], v[10:11], v[4:5]
    v_pk_mul_f32 v[12:13], v[12:13], v[6:7]
    v_pk_mul_f32 v[14:15], v[14:15], v[8:9]
    v_cvt_pk_bf16_f32 v108, v10, v11
    v_cvt_pk_bf16_f32 v109, v12, v13
    v_cvt_pk_bf16_f32 v110, v14, v15
    s_cbranch_execz L_sk29
    buffer_store_dwordx3 v[108:110], v1, s[20:23], s41 offen offset:2304 sc1
L_sk29:
    v_lshlrev_b32 v10, 16, v112
    v_and_b32 v11, s42, v112
    v_lshlrev_b32 v12, 16, v113
    v_and_b32 v13, s42, v113
    v_lshlrev_b32 v14, 16, v114
    v_and_b32 v15, s42, v114
    v_pk_mul_f32 v[10:11], v[10:11], v[4:5]
    v_pk_mul_f32 v[12:13], v[12:13], v[6:7]
    v_pk_mul_f32 v[14:15], v[14:15], v[8:9]
    v_cvt_pk_bf16_f32 v112, v10, v11
    v_cvt_pk_bf16_f32 v113, v12, v13
    v_cvt_pk_bf16_f32 v114, v14, v15
    s_add_u32 s41, s41, 12582912
    s_cbranch_execz L_sk30
    buffer_store_dwordx3 v[112:114], v1, s[20:23], s41 offen offset:0 sc1
L_sk30:
    v_lshlrev_b32 v10, 16, v152
    v_and_b32 v11, s42, v152
    v_lshlrev_b32 v12, 16, v153
    v_and_b32 v13, s42, v153
    v_lshlrev_b32 v14, 16, v154
    v_and_b32 v15, s42, v154
    v_pk_mul_f32 v[10:11], v[10:11], v[4:5]
    v_pk_mul_f32 v[12:13], v[12:13], v[6:7]
    v_pk_mul_f32 v[14:15], v[14:15], v[8:9]
    v_cvt_pk_bf16_f32 v152, v10, v11
    v_cvt_pk_bf16_f32 v153, v12, v13
    v_cvt_pk_bf16_f32 v154, v14, v15
    s_cbranch_vccnz L_th31
    s_waitcnt vmcnt(0)
L_th31:
    s_cbranch_execz L_sk31
    buffer_store_dwordx3 v[152:154], v1, s[20:23], s61 offen offset:1536 sc1
L_sk31:
    v_lshlrev_b32 v10, 16, v116
    v_and_b32 v11, s42, v116
    v_lshlrev_b32 v12, 16, v117
    v_and_b32 v13, s42, v117
    v_lshlrev_b32 v14, 16, v118
    v_and_b32 v15, s42, v118
    v_pk_mul_f32 v[10:11], v[10:11], v[4:5]
    v_pk_mul_f32 v[12:13], v[12:13], v[6:7]
    v_pk_mul_f32 v[14:15], v[14:15], v[8:9]
    v_cvt_pk_bf16_f32 v116, v10, v11
    v_cvt_pk_bf16_f32 v117, v12, v13
    v_cvt_pk_bf16_f32 v118, v14, v15
    s_cbranch_execz L_sk32
    buffer_store_dwordx3 v[116:118], v1, s[20:23], s41 offen offset:768 sc1
L_sk32:
    v_lshlrev_b32 v10, 16, v120
    v_and_b32 v11, s42, v120
    v_lshlrev_b32 v12, 16, v121
    v_and_b32 v13, s42, v121
    v_lshlrev_b32 v14, 16, v122
    v_and_b32 v15, s42, v122
    v_pk_mul_f32 v[10:11], v[10:11], v[4:5]
    v_pk_mul_f32 v[12:13], v[12:13], v[6:7]
    v_pk_mul_f32 v[14:15], v[14:15], v[8:9]
    v_cvt_pk_bf16_f32 v120, v10, v11
    v_cvt_pk_bf16_f32 v121, v12, v13
    v_cvt_pk_bf16_f32 v122, v14, v15
    s_cbranch_execz L_sk33
    buffer_store_dwordx3 v[120:122], v1, s[20:23], s41 offen offset:1536 sc1
L_sk33:
    v_lshlrev_b32 v10, 16, v124
    v_and_b32 v11, s42, v124
    v_lshlrev_b32 v12, 16, v125
    v_and_b32 v13, s42, v125
    v_lshlrev_b32 v14, 16, v126
    v_and_b32 v15, s42, v126
    v_pk_mul_f32 v[10:11], v[10:11], v[4:5]
    v_pk_mul_f32 v[12:13], v[12:13], v[6:7]
    v_pk_mul_f32 v[14:15], v[14:15], v[8:9]
    v_cvt_pk_bf16_f32 v124, v10, v11
    v_cvt_pk_bf16_f32 v125, v12, v13
    v_cvt_pk_bf16_f32 v126, v14, v15
    s_cbranch_vccnz L_th34
    s_waitcnt vmcnt(0)
L_th34:
    s_cbranch_execz L_sk34
    buffer_store_dwordx3 v[124:126], v1, s[20:23], s41 offen offset:2304 sc1
L_sk34:
    v_lshlrev_b32 v10, 16, v156
    v_and_b32 v11, s42, v156
    v_lshlrev_b32 v12, 16, v157
    v_and_b32 v13, s42, v157
    v_lshlrev_b32 v14, 16, v158
    v_and_b32 v15, s42, v158
    v_pk_mul_f32 v[10:11], v[10:11], v[4:5]
    v_pk_mul_f32 v[12:13], v[12:13], v[6:7]
    v_pk_mul_f32 v[14:15], v[14:15], v[8:9]
    v_cvt_pk_bf16_f32 v156, v10, v11
    v_cvt_pk_bf16_f32 v157, v12, v13
    v_cvt_pk_bf16_f32 v158, v14, v15
    s_cbranch_execz L_sk35
    buffer_store_dwordx3 v[156:158], v1, s[20:23], s61 offen offset:2304 sc1
L_sk35:
    s_endpgm
L_dwait:
    s_sub_u32 s49, s49, 1
    s_cbranch_scc1 L_dok
    buffer_load_dwordx2 v[160:161], off, s[72:75], 0 offset:128 sc1
    s_waitcnt vmcnt(0)
    s_branch L_dchk
L_aux:
    s_cmpk_eq_u32 s36, 512
    s_cbranch_scc1 L_sync
    s_load_dwordx2 s[20:21], s[0:1], 24
    s_mov_b32 s22, s18
    s_mov_b32 s23, 0x20000
    s_cmp_ge_u32 s2, 56
    s_cbranch_scc1 L_warm
    s_load_dwordx4 s[12:15], s[0:1], 32
    s_setprio 3
    s_mov_b32 s46, 256
    s_mov_b32 s47, 0x20000
    s_cmp_lt_u32 s2, 8
    s_cbranch_scc1 L_clear
    s_lshr_b32 s50, s2, 3
    s_sub_u32 s50, s50, 1
    s_and_b32 s51, s2, 15
    s_and_b32 s52, s2, 2
    s_bitcmp1_b32 s50, 1
    s_cselect_b32 s53, 21, 12
    s_add_u32 s52, s52, s53
    s_bitcmp1_b32 s50, 2
    s_cselect_b32 s52, 0, s52
    s_lshl_b32 s52, s52, 21
    s_lshl_b32 s53, s51, 14
    s_add_u32 s52, s52, s53
    s_add_u32 s52, s52, 0x110000
    s_lshl_b32 s53, s51, 11
    s_and_b32 s53, s53, 0x1000
    s_lshl_b32 s51, s51, 8
    s_add_u32 s53, s53, s51
    s_getreg_b32 s40, hwreg(HW_REG_XCC_ID)
    s_and_b32 s40, s40, 7
    s_mov_b32 s54, 0
    s_waitcnt lgkmcnt(0)
    s_sub_u32 s55, s16, s20
    s_add_u32 s55, s55, 0x800
    s_bfe_u32 s55, s55, 0x1000c
    s_or_b32 s50, s50, s55
    s_bitcmp1_b32 s50, 0
    s_cselect_b32 s62, s20, s16
    s_cselect_b32 s63, s21, s17
    s_bitcmp1_b32 s50, 2
    s_cselect_b32 s62, s14, s62
    s_cselect_b32 s63, s15, s63
    s_add_u32 s62, s62, s52
    s_addc_u32 s63, s63, 0
    s_and_b32 s62, s62, 0xffffc000
    s_or_b32 s62, s62, s53
    s_lshr_b32 s56, s62, 19
    s_xor_b32 s56, s56, s40
    s_load_dword s64, s[62:63], 0 glc
    s_load_dwordx2 s[66:67], s[62:63], 8192 glc
    s_waitcnt lgkmcnt(2)
    s_nop 3
    s_getreg_b32 s65, hwreg(HW_REG_IB_STS, 8, 4)
    s_waitcnt lgkmcnt(0)
    s_cmp_eq_u32 s65, 2
    s_addc_u32 s54, s54, 0
    s_load_dword s64, s[62:63], 8192 glc
    s_load_dwordx2 s[66:67], s[62:63], 0 glc
    s_waitcnt lgkmcnt(2)
    s_nop 3
    s_getreg_b32 s65, hwreg(HW_REG_IB_STS, 8, 4)
    s_waitcnt lgkmcnt(0)
    s_cmp_lg_u32 s65, 2
    s_addc_u32 s54, s54, 0
    s_load_dword s64, s[62:63], 0 glc
    s_load_dwordx2 s[66:67], s[62:63], 8192 glc
    s_waitcnt lgkmcnt(2)
    s_nop 3
    s_getreg_b32 s65, hwreg(HW_REG_IB_STS, 8, 4)
    s_waitcnt lgkmcnt(0)
    s_cmp_eq_u32 s65, 2
    s_addc_u32 s54, s54, 0
    s_mov_b32 s44, s12
    s_and_b32 s45, s13, 0xffff
    s_sub_u32 s55, 3, s54
    s_bitcmp1_b32 s56, 2
    s_cselect_b32 s54, s54, s55
    s_mov_b64 exec, 1
    s_bitcmp1_b32 s50, 2
    s_cbranch_scc1 L_wsvote
    s_mul_i32 s50, s50, 6
    s_lshl_b32 s54, s54, s50
    s_lshl_b32 s40, s40, 8
    s_cmp_eq_u32 s2, 8
    s_cselect_b32 s55, s40, 0
    s_add_u32 s55, s55, 0x10000
    v_mov_b32 v4, s54
    v_mov_b32 v5, s55
    buffer_atomic_add_x2 v[4:5], off, s[44:47], 0 offset:128
L_warm:
    s_setprio 0
    s_mov_b64 vcc, -1
    s_mov_b64 exec, 0
    s_branch L_store
L_wsvote:
    s_add_u32 s54, s54, 0x8000
    v_mov_b32 v4, s54
    buffer_atomic_add v4, off, s[44:47], 0 offset:64
    s_branch L_warm
L_clear:
    v_mov_b32 v8, 0
    v_mov_b32 v9, 0
    v_mov_b32 v10, 0
    v_mov_b32 v11, 0
    v_lshlrev_b32 v1, 4, v0
    s_lshl_b32 s53, s2, 12
    s_mov_b32 s34, 32768
    s_mov_b32 s35, 0x20000
    s_waitcnt lgkmcnt(0)
    s_add_u32 s32, s14, 1048576
    s_addc_u32 s33, s15, 0
    s_and_b32 s32, s32, 0xffffc000
    s_and_b32 s33, s33, 0xffff
    s_mov_b32 s44, s12
    s_and_b32 s45, s13, 0xffff
    buffer_store_dwordx4 v[8:11], v1, s[32:35], s53 offen offset:0 sc1
    buffer_store_dwordx4 v[8:11], v1, s[32:35], s53 offen offset:1024 sc1
    buffer_store_dwordx4 v[8:11], v1, s[32:35], s53 offen offset:2048 sc1
    buffer_store_dwordx4 v[8:11], v1, s[32:35], s53 offen offset:3072 sc1
    v_mov_b32 v5, 0x10000
    s_waitcnt vmcnt(0)
    s_mov_b64 exec, 1
    buffer_atomic_add v5, off, s[44:47], 0
    s_branch L_warm
L_sync:
    s_load_dwordx2 s[24:25], s[0:1], 8
    s_load_dwordx2 s[28:29], s[0:1], 16
    s_load_dwordx4 s[12:15], s[0:1], 32
    v_lshlrev_b32 v1, 4, v0
    v_lshlrev_b32 v4, 2, v0
    v_and_b32 v9, 1, v0
    v_lshlrev_b32 v7, 13, v9
    v_and_b32 v6, 48, v0
    v_add_u32 v7, v7, v6
    v_lshlrev_b32 v9, 6, v9
    v_and_b32 v5, 31, v0
    v_lshrrev_b32 v6, 5, v0
    v_lshl_add_u32 v6, v5, 1, v6
    v_mul_u32_u24 v6, 72, v6
    v_lshlrev_b32 v2, 1, v0
    v_lshlrev_b32 v3, 4, v0
    s_mov_b32 s26, 4608
    s_mov_b32 s27, 0x20000
    s_mov_b32 s30, 4608
    s_mov_b32 s31, 0x20000
    s_mov_b32 s34, 32768
    s_mov_b32 s35, 0x20000
    s_mov_b32 s46, 256
    s_mov_b32 s47, 0x20000
    s_movk_i32 s50, 0x1000
    s_movk_i32 s51, 0x4000
    s_movk_i32 s52, 0x5000
    s_movk_i32 s53, 0x900
    s_mov_b32 s42, 0xffff0000
    s_and_b32 s43, s2, 127
    s_lshl_b32 s43, s43, 6
    s_lshr_b32 s55, s2, 7
    s_lshl_b32 s55, s55, 14
    s_add_u32 s43, s43, s55
    s_mov_b32 s54, 3000000
    s_mov_b32 s56, 0x00030003
    s_mov_b32 s57, 0x00030003
    s_mov_b32 s58, 0x36e38e39
    s_mov_b32 s59, 0xbfb8aa3b
    s_waitcnt lgkmcnt(0)
    s_add_u32 s32, s14, 1048576
    s_addc_u32 s33, s15, 0
    s_and_b32 s32, s32, 0xffffc000
    s_and_b32 s33, s33, 0xffff
    s_mov_b32 s44, s12
    s_and_b32 s45, s13, 0xffff
    s_mov_b64 exec, 0
    s_branch L_crit
L_arm:
    s_mov_b64 exec, -1
    s_setprio 3
    buffer_load_dwordx4 v[88:91], v6, s[24:27], 0 offen offset:0
    buffer_load_dwordx4 v[92:95], v6, s[24:27], 0 offen offset:16
    buffer_load_dwordx4 v[96:99], v6, s[24:27], 0 offen offset:32
    buffer_load_dwordx4 v[100:103], v6, s[24:27], 0 offen offset:48
    buffer_load_dwordx2 v[104:105], v6, s[24:27], 0 offen offset:64
    v_mov_b32 v40, 0
    v_mov_b32 v41, 0
    v_mov_b32 v42, 0
    v_mov_b32 v43, 0
    v_mov_b32 v44, 0
    v_mov_b32 v45, 0
    v_mov_b32 v46, 0
    v_mov_b32 v47, 0
    v_mov_b32 v48, 0
    v_mov_b32 v49, 0
    v_mov_b32 v50, 0
    v_mov_b32 v51, 0
    buffer_load_dword v108, v4, s[28:31], 0 offen offset:0
    buffer_load_dword v109, v4, s[28:31], 0 offen offset:384
    buffer_load_dword v110, v4, s[28:31], 0 offen offset:768
    buffer_load_dword v111, v4, s[28:31], 0 offen offset:1152
    buffer_load_dword v112, v4, s[28:31], 0 offen offset:1536
    buffer_load_dword v113, v4, s[28:31], 0 offen offset:1920
    buffer_load_dword v114, v4, s[28:31], 0 offen offset:2304
    buffer_load_dword v115, v4, s[28:31], 0 offen offset:2688
    buffer_load_dword v116, v4, s[28:31], 0 offen offset:3072
    buffer_load_dword v117, v4, s[28:31], 0 offen offset:3456
    buffer_load_dword v118, v4, s[28:31], 0 offen offset:3840
    buffer_load_dword v119, v4, s[28:31], s53 offen offset:1920
    buffer_load_short_d16_hi v40, v2, s[28:31], 0 offen offset:256
    buffer_load_short_d16_hi v41, v2, s[28:31], 0 offen offset:640
    buffer_load_short_d16_hi v42, v2, s[28:31], 0 offen offset:1024
    buffer_load_short_d16_hi v43, v2, s[28:31], 0 offen offset:1408
    buffer_load_short_d16_hi v44, v2, s[28:31], 0 offen offset:1792
    buffer_load_short_d16_hi v45, v2, s[28:31], 0 offen offset:2176
    buffer_load_short_d16_hi v46, v2, s[28:31], 0 offen offset:2560
    buffer_load_short_d16_hi v47, v2, s[28:31], 0 offen offset:2944
    buffer_load_short_d16_hi v48, v2, s[28:31], 0 offen offset:3328
    buffer_load_short_d16_hi v49, v2, s[28:31], 0 offen offset:3712
    buffer_load_short_d16_hi v50, v2, s[28:31], s53 offen offset:1792
    buffer_load_short_d16_hi v51, v2, s[28:31], s53 offen offset:2176
    s_waitcnt vmcnt(0)
    v_lshlrev_b32 v52, 16, v88
    v_and_b32 v53, s42, v88
    v_lshlrev_b32 v54, 16, v89
    v_and_b32 v55, s42, v89
    v_lshlrev_b32 v56, 16, v90
    v_and_b32 v57, s42, v90
    v_lshlrev_b32 v58, 16, v91
    v_and_b32 v59, s42, v91
    v_lshlrev_b32 v60, 16, v92
    v_and_b32 v61, s42, v92
    v_lshlrev_b32 v62, 16, v93
    v_and_b32 v63, s42, v93
    v_lshlrev_b32 v64, 16, v94
    v_and_b32 v65, s42, v94
    v_lshlrev_b32 v66, 16, v95
    v_and_b32 v67, s42, v95
    v_lshlrev_b32 v68, 16, v96
    v_and_b32 v69, s42, v96
    v_lshlrev_b32 v70, 16, v97
    v_and_b32 v71, s42, v97
    v_lshlrev_b32 v72, 16, v98
    v_and_b32 v73, s42, v98
    v_lshlrev_b32 v74, 16, v99
    v_and_b32 v75, s42, v99
    v_lshlrev_b32 v76, 16, v100
    v_and_b32 v77, s42, v100
    v_lshlrev_b32 v78, 16, v101
    v_and_b32 v79, s42, v101
    v_lshlrev_b32 v80, 16, v102
    v_and_b32 v81, s42, v102
    v_lshlrev_b32 v82, 16, v103
    v_and_b32 v83, s42, v103
    v_lshlrev_b32 v84, 16, v104
    v_and_b32 v85, s42, v104
    v_lshlrev_b32 v86, 16, v105
    v_and_b32 v87, s42, v105
    v_lshlrev_b32 v16, 16, v108
    v_and_b32 v17, s42, v108
    v_lshlrev_b32 v18, 16, v109
    v_and_b32 v19, s42, v109
    v_lshlrev_b32 v20, 16, v110
    v_and_b32 v21, s42, v110
    v_lshlrev_b32 v22, 16, v111
    v_and_b32 v23, s42, v111
    v_lshlrev_b32 v24, 16, v112
    v_and_b32 v25, s42, v112
    v_lshlrev_b32 v26, 16, v113
    v_and_b32 v27, s42, v113
    v_lshlrev_b32 v28, 16, v114
    v_and_b32 v29, s42, v114
    v_lshlrev_b32 v30, 16, v115
    v_and_b32 v31, s42, v115
    v_lshlrev_b32 v32, 16, v116
    v_and_b32 v33, s42, v116
    v_lshlrev_b32 v34, 16, v117
    v_and_b32 v35, s42, v117
    v_lshlrev_b32 v36, 16, v118
    v_and_b32 v37, s42, v118
    v_lshlrev_b32 v38, 16, v119
    v_and_b32 v39, s42, v119
    v_mul_f32 v52, s58, v52
    v_mul_f32 v53, s58, v53
    v_mul_f32 v54, s58, v54
    v_mul_f32 v55, s58, v55
    v_mul_f32 v56, s58, v56
    v_mul_f32 v57, s58, v57
    v_mul_f32 v58, s58, v58
    v_mul_f32 v59, s58, v59
    v_mul_f32 v60, s58, v60
    v_mul_f32 v61, s58, v61
    v_mul_f32 v62, s58, v62
    v_mul_f32 v63, s58, v63
    v_mul_f32 v64, s58, v64
    v_mul_f32 v65, s58, v65
    v_mul_f32 v66, s58, v66
    v_mul_f32 v67, s58, v67
    v_mul_f32 v68, s58, v68
    v_mul_f32 v69, s58, v69
    v_mul_f32 v70, s58, v70
    v_mul_f32 v71, s58, v71
    v_mul_f32 v72, s58, v72
    v_mul_f32 v73, s58, v73
    v_mul_f32 v74, s58, v74
    v_mul_f32 v75, s58, v75
    v_mul_f32 v76, s58, v76
    v_mul_f32 v77, s58, v77
    v_mul_f32 v78, s58, v78
    v_mul_f32 v79, s58, v79
    v_mul_f32 v80, s58, v80
    v_mul_f32 v81, s58, v81
    v_mul_f32 v82, s58, v82
    v_mul_f32 v83, s58, v83
    v_mul_f32 v84, s58, v84
    v_mul_f32 v85, s58, v85
    v_mul_f32 v86, s58, v86
    v_mul_f32 v87, s58, v87
    v_mul_f32 v16, s59, v16
    v_mul_f32 v17, s59, v17
    v_mul_f32 v18, s59, v18
    v_mul_f32 v19, s59, v19
    v_mul_f32 v20, s59, v20
    v_mul_f32 v21, s59, v21
    v_mul_f32 v22, s59, v22
    v_mul_f32 v23, s59, v23
    v_mul_f32 v24, s59, v24
    v_mul_f32 v25, s59, v25
    v_mul_f32 v26, s59, v26
    v_mul_f32 v27, s59, v27
    v_mul_f32 v28, s59, v28
    v_mul_f32 v29, s59, v29
    v_mul_f32 v30, s59, v30
    v_mul_f32 v31, s59, v31
    v_mul_f32 v32, s59, v32
    v_mul_f32 v33, s59, v33
    v_mul_f32 v34, s59, v34
    v_mul_f32 v35, s59, v35
    v_mul_f32 v36, s59, v36
    v_mul_f32 v37, s59, v37
    v_mul_f32 v38, s59, v38
    v_mul_f32 v39, s59, v39
    v_mul_f32 v40, s59, v40
    v_mul_f32 v41, s59, v41
    v_mul_f32 v42, s59, v42
    v_mul_f32 v43, s59, v43
    v_mul_f32 v44, s59, v44
    v_mul_f32 v45, s59, v45
    v_mul_f32 v46, s59, v46
    v_mul_f32 v47, s59, v47
    v_mul_f32 v48, s59, v48
    v_mul_f32 v49, s59, v49
    v_mul_f32 v50, s59, v50
    v_mul_f32 v51, s59, v51
L_flag:
    buffer_load_dword v5, v9, s[44:47], 0 offen sc1
    s_sub_u32 s54, s54, 1
    s_cbranch_scc1 L_flagok
    s_waitcnt vmcnt(0)
    v_cmp_gt_u32 vcc, 0x80000, v5
    s_cbranch_vccz L_flagok
    s_sleep 8
    s_branch L_flag
L_flagok:
    s_waitcnt vmcnt(0)
    s_getreg_b32 s55, hwreg(HW_REG_XCC_ID)
    v_readlane_b32 s37, v5, 1
    s_lshr_b32 s55, s55, 2
    s_lshr_b32 s38, s32, 21
    s_xor_b32 s55, s55, s38
    s_add_u32 s37, s37, 39
    s_lshr_b32 s37, s37, 6
    s_xor_b32 s55, s55, s37
    s_and_b32 s55, s55, 1
    s_lshl_b32 s55, s55, 13
    v_add_u32 v1, s55, v1
    v_mov_b32 v11, 1.0
    v_lshlrev_b32 v2, 3, v0
    s_mov_b32 s54, 3000000
L_crit:
    s_cbranch_execz L_c1
    s_barrier
L_c1:
    ds_read_b128 v[88:91], v3 offset:0
    ds_read_b128 v[92:95], v3 offset:1024
    ds_read_b128 v[96:99], v3 offset:2048
    ds_read_b128 v[100:103], v3 offset:3072
    ds_read_b128 v[104:107], v3 offset:4096
    ds_read_b128 v[108:111], v3 offset:5120
    s_waitcnt lgkmcnt(4)
    v_pk_add_f32 v[88:89], v[88:89], v[90:91]
    v_pk_add_f32 v[92:93], v[92:93], v[94:95]
    v_pk_add_f32 v[88:89], v[88:89], v[92:93]
    s_waitcnt lgkmcnt(2)
    v_pk_add_f32 v[96:97], v[96:97], v[98:99]
    v_pk_add_f32 v[100:101], v[100:101], v[102:103]
    v_add_f32 v12, v88, v89
    v_pk_add_f32 v[96:97], v[96:97], v[100:101]
    s_waitcnt lgkmcnt(0)
    v_pk_add_f32 v[104:105], v[104:105], v[106:107]
    v_pk_add_f32 v[108:109], v[108:109], v[110:111]
    v_add_f32 v14, v96, v97
    v_pk_add_f32 v[104:105], v[104:105], v[108:109]
    v_pk_mul_f32 v[112:113], v[12:13], v[52:53] op_sel_hi:[0,1]
    v_pk_mul_f32 v[114:115], v[12:13], v[54:55] op_sel_hi:[0,1]
    v_pk_mul_f32 v[116:117], v[12:13], v[56:57] op_sel_hi:[0,1]
    v_pk_mul_f32 v[118:119], v[12:13], v[58:59] op_sel_hi:[0,1]
    v_pk_mul_f32 v[120:121], v[12:13], v[60:61] op_sel_hi:[0,1]
    v_pk_mul_f32 v[122:123], v[12:13], v[62:63] op_sel_hi:[0,1]
    v_add_f32 v12, v104, v105
    v_pk_fma_f32 v[112:113], v[14:15], v[64:65], v[112:113] op_sel_hi:[0,1,1]
    v_pk_fma_f32 v[114:115], v[14:15], v[66:67], v[114:115] op_sel_hi:[0,1,1]
    v_pk_fma_f32 v[116:117], v[14:15], v[68:69], v[116:117] op_sel_hi:[0,1,1]
    v_pk_fma_f32 v[118:119], v[14:15], v[70:71], v[118:119] op_sel_hi:[0,1,1]
    v_pk_fma_f32 v[120:121], v[14:15], v[72:73], v[120:121] op_sel_hi:[0,1,1]
    v_pk_fma_f32 v[122:123], v[14:15], v[74:75], v[122:123] op_sel_hi:[0,1,1]
    v_pk_fma_f32 v[112:113], v[12:13], v[76:77], v[112:113] op_sel_hi:[0,1,1]
    v_pk_fma_f32 v[114:115], v[12:13], v[78:79], v[114:115] op_sel_hi:[0,1,1]
    v_pk_fma_f32 v[116:117], v[12:13], v[80:81], v[116:117] op_sel_hi:[0,1,1]
    v_pk_fma_f32 v[118:119], v[12:13], v[82:83], v[118:119] op_sel_hi:[0,1,1]
    v_pk_fma_f32 v[120:121], v[12:13], v[84:85], v[120:121] op_sel_hi:[0,1,1]
    v_pk_fma_f32 v[122:123], v[12:13], v[86:87], v[122:123] op_sel_hi:[0,1,1]
    v_permlane32_swap_b32 v112, v118
    v_permlane32_swap_b32 v113, v119
    v_permlane32_swap_b32 v114, v120
    v_permlane32_swap_b32 v115, v121
    v_permlane32_swap_b32 v116, v122
    v_permlane32_swap_b32 v117, v123
    v_add_f32 v112, v112, v118
    v_add_f32 v113, v113, v119
    v_add_f32 v114, v114, v120
    v_add_f32 v115, v115, v121
    v_add_f32 v116, v116, v122
    v_add_f32 v117, v117, v123
    v_permlane16_swap_b32 v112, v115
    v_permlane16_swap_b32 v113, v116
    v_permlane16_swap_b32 v114, v117
    v_add_f32 v8, v112, v115
    v_add_f32 v9, v113, v116
    v_add_f32 v10, v114, v117
    v_add_f32_dpp v8, v8, v8 row_ror:8 row_mask:0xf bank_mask:0xf
    v_add_f32_dpp v9, v9, v9 row_ror:8 row_mask:0xf bank_mask:0xf
    v_add_f32_dpp v10, v10, v10 row_ror:8 row_mask:0xf bank_mask:0xf
    v_add_f32_dpp v8, v8, v8 row_ror:4 row_mask:0xf bank_mask:0xf
    v_add_f32_dpp v9, v9, v9 row_ror:4 row_mask:0xf bank_mask:0xf
    v_add_f32_dpp v10, v10, v10 row_ror:4 row_mask:0xf bank_mask:0xf
    v_add_f32_dpp v8, v8, v8 row_ror:2 row_mask:0xf bank_mask:0xf
    v_add_f32_dpp v9, v9, v9 row_ror:2 row_mask:0xf bank_mask:0xf
    v_add_f32_dpp v10, v10, v10 row_ror:2 row_mask:0xf bank_mask:0xf
    v_add_f32_dpp v8, v8, v8 row_ror:1 row_mask:0xf bank_mask:0xf
    v_add_f32_dpp v9, v9, v9 row_ror:1 row_mask:0xf bank_mask:0xf
    v_add_f32_dpp v10, v10, v10 row_ror:1 row_mask:0xf bank_mask:0xf
    s_cbranch_execz L_p0
    s_mov_b64 exec, s[56:57]
    buffer_store_dwordx4 v[8:11], v7, s[32:35], s43 offen sc1
    s_mov_b64 exec, -1
    s_waitcnt vmcnt(0)
L_poll:
    s_sub_u32 s54, s54, 1
    s_cbranch_scc1 L_gate
    buffer_load_dwordx4 v[52:55], v1, s[32:35], 0 offen offset:0 sc1
    buffer_load_dwordx4 v[56:59], v1, s[32:35], 0 offen offset:1024 sc1
    buffer_load_dwordx4 v[60:63], v1, s[32:35], 0 offen offset:2048 sc1
L_p0:
    s_cbranch_execz L_p1
    buffer_load_dwordx4 v[64:67], v1, s[32:35], 0 offen offset:3072 sc1
    buffer_load_dwordx4 v[68:71], v1, s[32:35], s50 offen offset:0 sc1
    buffer_load_dwordx4 v[72:75], v1, s[32:35], s50 offen offset:1024 sc1
    buffer_load_dwordx4 v[76:79], v1, s[32:35], s50 offen offset:2048 sc1
    buffer_load_dwordx4 v[80:83], v1, s[32:35], s50 offen offset:3072 sc1
    buffer_load_dwordx4 v[84:87], v1, s[32:35], s51 offen offset:0 sc1
L_p1:
    s_cbranch_execz L_p2
    buffer_load_dwordx4 v[88:91], v1, s[32:35], s51 offen offset:1024 sc1
    buffer_load_dwordx4 v[92:95], v1, s[32:35], s51 offen offset:2048 sc1
    buffer_load_dwordx4 v[96:99], v1, s[32:35], s51 offen offset:3072 sc1
    buffer_load_dwordx4 v[100:103], v1, s[32:35], s52 offen offset:0 sc1
    buffer_load_dwordx4 v[104:107], v1, s[32:35], s52 offen offset:1024 sc1
    buffer_load_dwordx4 v[108:111], v1, s[32:35], s52 offen offset:2048 sc1
    buffer_load_dwordx4 v[112:115], v1, s[32:35], s52 offen offset:3072 sc1
L_p2:
    s_waitcnt vmcnt(14)
    v_pk_add_f32 v[12:13], v[52:53], v[56:57]
    v_pk_add_f32 v[14:15], v[54:55], v[58:59]
    s_waitcnt vmcnt(13)
    v_pk_add_f32 v[12:13], v[12:13], v[60:61]
    v_pk_add_f32 v[14:15], v[14:15], v[62:63]
    s_waitcnt vmcnt(12)
    v_pk_add_f32 v[12:13], v[12:13], v[64:65]
    v_pk_add_f32 v[14:15], v[14:15], v[66:67]
    s_waitcnt vmcnt(11)
    v_pk_add_f32 v[12:13], v[12:13], v[68:69]
    v_pk_add_f32 v[14:15], v[14:15], v[70:71]
    s_waitcnt vmcnt(10)
    v_pk_add_f32 v[12:13], v[12:13], v[72:73]
    v_pk_add_f32 v[14:15], v[14:15], v[74:75]
    s_waitcnt vmcnt(9)
    v_pk_add_f32 v[12:13], v[12:13], v[76:77]
    v_pk_add_f32 v[14:15], v[14:15], v[78:79]
    s_waitcnt vmcnt(8)
    v_pk_add_f32 v[12:13], v[12:13], v[80:81]
    v_pk_add_f32 v[14:15], v[14:15], v[82:83]
    s_waitcnt vmcnt(7)
    v_pk_add_f32 v[12:13], v[12:13], v[84:85]
    v_pk_add_f32 v[14:15], v[14:15], v[86:87]
    s_waitcnt vmcnt(6)
    v_pk_add_f32 v[12:13], v[12:13], v[88:89]
    v_pk_add_f32 v[14:15], v[14:15], v[90:91]
    s_waitcnt vmcnt(5)
    v_pk_add_f32 v[12:13], v[12:13], v[92:93]
    v_pk_add_f32 v[14:15], v[14:15], v[94:95]
    s_waitcnt vmcnt(4)
    v_pk_add_f32 v[12:13], v[12:13], v[96:97]
    v_pk_add_f32 v[14:15], v[14:15], v[98:99]
    s_waitcnt vmcnt(3)
    v_pk_add_f32 v[12:13], v[12:13], v[100:101]
    v_pk_add_f32 v[14:15], v[14:15], v[102:103]
    s_waitcnt vmcnt(2)
    v_pk_add_f32 v[12:13], v[12:13], v[104:105]
    v_pk_add_f32 v[14:15], v[14:15], v[106:107]
    s_waitcnt vmcnt(1)
    v_pk_add_f32 v[12:13], v[12:13], v[108:109]
    v_pk_add_f32 v[14:15], v[14:15], v[110:111]
    s_waitcnt vmcnt(0)
    v_pk_add_f32 v[12:13], v[12:13], v[112:113]
    v_pk_add_f32 v[14:15], v[14:15], v[114:115]
    v_cmp_neq_f32 vcc, 0x41800000, v15
    s_cbranch_vccnz L_poll
L_gate:
    v_add_f32_dpp v12, v12, v12 row_ror:4 row_mask:0xf bank_mask:0xf
    v_add_f32_dpp v13, v13, v13 row_ror:4 row_mask:0xf bank_mask:0xf
    v_add_f32_dpp v14, v14, v14 row_ror:4 row_mask:0xf bank_mask:0xf
    v_add_f32_dpp v12, v12, v12 row_ror:8 row_mask:0xf bank_mask:0xf
    v_add_f32_dpp v13, v13, v13 row_ror:8 row_mask:0xf bank_mask:0xf
    v_add_f32_dpp v14, v14, v14 row_ror:8 row_mask:0xf bank_mask:0xf
    v_mov_b32 v15, v14
    s_nop 0
    v_permlane32_swap_b32 v12, v13
    v_permlane32_swap_b32 v14, v15
    s_nop 0
    v_add_f32 v12, v12, v13
    v_add_f32 v14, v14, v15
    s_nop 1
    v_permlane16_swap_b32 v12, v14
    s_nop 0
    v_add_f32 v8, v12, v14
    v_mul_f32 v9, s59, v8
    v_exp_f32 v9, v9
    s_nop 0
    v_add_f32 v9, 1.0, v9
    v_rcp_f32 v9, v9
    s_nop 0
    v_mul_f32 v8, v8, v9
    s_nop 0
    v_readlane_b32 s60, v8, 0
    v_readlane_b32 s61, v8, 32
    v_readlane_b32 s62, v8, 16
    v_readlane_b32 s63, v8, 1
    v_readlane_b32 s64, v8, 33
    v_readlane_b32 s65, v8, 17
    v_readlane_b32 s66, v8, 2
    v_readlane_b32 s67, v8, 34
    v_readlane_b32 s68, v8, 18
    v_readlane_b32 s69, v8, 3
    v_readlane_b32 s70, v8, 35
    v_readlane_b32 s71, v8, 19
    v_pk_mul_f32 v[12:13], s[60:61], v[16:17] op_sel_hi:[0,1]
    v_pk_mul_f32 v[14:15], s[60:61], v[40:41]
    v_pk_fma_f32 v[12:13], s[60:61], v[18:19], v[12:13] op_sel:[1,0,0] op_sel_hi:[1,1,1]
    v_pk_fma_f32 v[12:13], s[62:63], v[20:21], v[12:13] op_sel_hi:[0,1,1]
    v_pk_fma_f32 v[14:15], s[62:63], v[42:43], v[14:15]
    v_pk_fma_f32 v[12:13], s[62:63], v[22:23], v[12:13] op_sel:[1,0,0] op_sel_hi:[1,1,1]
    v_pk_fma_f32 v[12:13], s[64:65], v[24:25], v[12:13] op_sel_hi:[0,1,1]
    v_pk_fma_f32 v[14:15], s[64:65], v[44:45], v[14:15]
    v_pk_fma_f32 v[12:13], s[64:65], v[26:27], v[12:13] op_sel:[1,0,0] op_sel_hi:[1,1,1]
    v_pk_fma_f32 v[12:13], s[66:67], v[28:29], v[12:13] op_sel_hi:[0,1,1]
    v_pk_fma_f32 v[14:15], s[66:67], v[46:47], v[14:15]
    v_pk_fma_f32 v[12:13], s[66:67], v[30:31], v[12:13] op_sel:[1,0,0] op_sel_hi:[1,1,1]
    v_pk_fma_f32 v[12:13], s[68:69], v[32:33], v[12:13] op_sel_hi:[0,1,1]
    v_pk_fma_f32 v[14:15], s[68:69], v[48:49], v[14:15]
    v_pk_fma_f32 v[12:13], s[68:69], v[34:35], v[12:13] op_sel:[1,0,0] op_sel_hi:[1,1,1]
    v_pk_fma_f32 v[12:13], s[70:71], v[36:37], v[12:13] op_sel_hi:[0,1,1]
    v_pk_fma_f32 v[14:15], s[70:71], v[50:51], v[14:15]
    v_pk_fma_f32 v[12:13], s[70:71], v[38:39], v[12:13] op_sel:[1,0,0] op_sel_hi:[1,1,1]
    v_add_f32 v14, v14, v15
    v_exp_f32 v12, v12
    v_exp_f32 v13, v13
    v_exp_f32 v14, v14
    v_add_f32 v12, 1.0, v12
    v_add_f32 v13, 1.0, v13
    v_add_f32 v14, 1.0, v14
    v_rcp_f32 v12, v12
    v_rcp_f32 v13, v13
    v_rcp_f32 v14, v14
    v_cvt_pk_bf16_f32 v13, v12, v13
    v_cvt_pk_bf16_f32 v14, v14, v14
    v_lshlrev_b32 v12, 16, v13
    v_and_b32 v13, s42, v13
    v_and_b32 v14, s42, v14
    ds_write_b64 v2, v[12:13] offset:6144
    ds_write_b32 v4, v14 offset:6656
    s_waitcnt lgkmcnt(0)
    s_cbranch_execz L_arm
    s_barrier
L_end:
    s_endpgm
.section .rodata,"a"
.p2align 6
.amdhsa_kernel standalone__channel_attn_se__vision_kernel
  .amdhsa_next_free_vgpr 162
  .amdhsa_next_free_sgpr 80
  .amdhsa_accum_offset 164
  .amdhsa_group_segment_fixed_size 0
  .amdhsa_kernarg_size 48
  .amdhsa_user_sgpr_count 2
  .amdhsa_user_sgpr_kernarg_segment_ptr 1
  .amdhsa_system_sgpr_workgroup_id_x 1
  .amdhsa_float_denorm_mode_32 3
.end_amdhsa_kernel
```
